```python
import torch

def _softmax(x, axis=-1):
    return torch.softmax(x, dim=axis)
def _gelu(x):
    return torch.nn.functional.gelu(x, approximate="tanh")
def _silu(x):
    return torch.nn.functional.silu(x)
def _sigmoid(x):
    return torch.sigmoid(x)
def _layernorm(x, axis=-1, eps=1e-5):
    m = x.mean(dim=axis, keepdim=True)
    v = x.var(dim=axis, keepdim=True, unbiased=False)
    return (x - m) / torch.sqrt(v + eps)
def _scatter_add(tgt, idx, src, axis=0):
    return tgt.clone().index_add_(axis, idx, src)
def _segment_sum(src, seg, n):
    out = torch.zeros((n,) + src.shape[1:], dtype=src.dtype)
    return out.index_add_(0, seg, src)
def _pad(x, pw):
    flat = tuple(v for pair in reversed(pw) for v in pair)
    return torch.nn.functional.pad(x, flat)

kernel_name = 'concat_heads__gqa_block_cached__sliding_block_cached__decode'

def setup_inputs():

    _w = (lambda a: (lambda t: t.to(torch.bfloat16) if t.is_floating_point() else t)(torch.as_tensor(a)))
    def _A_setup():
        B, Sq, D = 4, 1, 1024
        Hq, Hkv, Sk, Dh = 32, 4, 8192, 128
        assert Hq % Hkv == 0, (Hq, Hkv)
        return {
            "x": _w((lambda *s: torch.randn(*s, dtype=torch.bfloat16) * 0.8)(B, Sq, D)),
            "k_cache": _w((lambda *s: torch.randn(*s, dtype=torch.bfloat16) * 1.6)(B, Hkv, Sk, Dh)),
            "v_cache": _w((lambda *s: torch.randn(*s, dtype=torch.bfloat16) * 0.2)(B, Hkv, Sk, Dh)),
            "wq": _w((lambda *s: torch.randn(*s, dtype=torch.bfloat16) * 1.6)(D, Hq * Dh) * (D ** -0.5)),
            "wo": _w((lambda *s: torch.randn(*s, dtype=torch.bfloat16) * 0.2)(Hq * Dh, D) * ((Hq * Dh) ** -0.5)),
        }
    _A_in = _A_setup()

    def _B_setup():
        B, Sq, D = 4, 1, 1024
        Hq, Hkv, Sk, Dh = 32, 4, 8192, 128
        assert Hq % Hkv == 0, (Hq, Hkv)
        return {
            "x": _w((lambda *s: torch.randn(*s, dtype=torch.bfloat16) * 0.8)(B, Sq, D)),
            "k_cache": _w((lambda *s: torch.randn(*s, dtype=torch.bfloat16) * 1.6)(B, Hkv, Sk, Dh)),
            "v_cache": _w((lambda *s: torch.randn(*s, dtype=torch.bfloat16) * 0.2)(B, Hkv, Sk, Dh)),
            "wq": _w((lambda *s: torch.randn(*s, dtype=torch.bfloat16) * 1.6)(D, Hq * Dh) * (D ** -0.5)),
            "wo": _w((lambda *s: torch.randn(*s, dtype=torch.bfloat16) * 0.2)(Hq * Dh, D) * ((Hq * Dh) ** -0.5)),
        }
    _B_in = _B_setup()

    return {
        "A_x": _A_in["x"],
        "A_k_cache": _A_in["k_cache"],
        "A_v_cache": _A_in["v_cache"],
        "A_wq": _A_in["wq"],
        "A_wo": _A_in["wo"],
        "B_x": _B_in["x"],
        "B_k_cache": _B_in["k_cache"],
        "B_v_cache": _B_in["v_cache"],
        "B_wq": _B_in["wq"],
        "B_wo": _B_in["wo"],
    }

def reference(A_x, A_k_cache, A_v_cache, A_wq, A_wo, B_x, B_k_cache, B_v_cache, B_wq, B_wo):
    def _A_ref(x, k_cache, v_cache, wq, wo):
        B, Sq, D = x.shape
        Hq, Dh = 32, 128
        Hkv = k_cache.shape[1]
        rep = Hq // Hkv
        q = (lambda x, *d: x.permute(*d))((x @ wq).reshape(B, Sq, Hq, Dh), 0, 2, 1, 3)
        k = (lambda x, n, axis: torch.repeat_interleave(x, n, dim=axis))(k_cache, rep, axis=1)
        v = (lambda x, n, axis: torch.repeat_interleave(x, n, dim=axis))(v_cache, rep, axis=1)
        scores = torch.einsum("bhqd,bhkd->bhqk", q, k) * (Dh ** -0.5)
        p = _softmax(scores, axis=-1)
        o = torch.einsum("bhqk,bhkd->bhqd", p, v)
        return (lambda x, *d: x.permute(*d))(o, 0, 2, 1, 3).reshape(B, Sq, Hq * Dh) @ wo

    def _B_ref(x, k_cache, v_cache, wq, wo):
        B, Sq, D = x.shape
        Hq, Dh = 32, 128
        Hkv, Sk = k_cache.shape[1], k_cache.shape[2]
        W = min(4096, max(256, Sk // 4))
        rep = Hq // Hkv
        q = (lambda x, *d: x.permute(*d))((x @ wq).reshape(B, Sq, Hq, Dh), 0, 2, 1, 3)
        k = (lambda x, n, axis: torch.repeat_interleave(x, n, dim=axis))(k_cache[:, :, Sk - W:, :], rep, axis=1)
        v = (lambda x, n, axis: torch.repeat_interleave(x, n, dim=axis))(v_cache[:, :, Sk - W:, :], rep, axis=1)
        scores = torch.einsum("bhqd,bhkd->bhqk", q, k) * (Dh ** -0.5)
        p = _softmax(scores, axis=-1)
        o = torch.einsum("bhqk,bhkd->bhqd", p, v)
        return (lambda x, *d: x.permute(*d))(o, 0, 2, 1, 3).reshape(B, Sq, Hq * Dh) @ wo

    a = _A_ref(A_x, A_k_cache, A_v_cache, A_wq, A_wo)
    b = _B_ref(B_x, B_k_cache, B_v_cache, B_wq, B_wo)
    return torch.concatenate([a, b], axis=-1)
```

```asm
; @launch grid=(256,1,1) block=(512,1,1) lds=105472
.amdgcn_target "amdgcn-amd-amdhsa--gfx950"
.text
.globl concat_heads__gqa_block_cached__sliding_block_cached__decode_kernel
.p2align 8
.type concat_heads__gqa_block_cached__sliding_block_cached__decode_kernel,@function
concat_heads__gqa_block_cached__sliding_block_cached__decode_kernel:
  s_cmp_ge_u32 s2, 256
  s_cbranch_scc1 L_end
  s_load_dwordx16 s[16:31], s[0:1], 0
  s_load_dwordx8 s[32:39], s[0:1], 64
  s_load_dwordx2 s[40:41], s[0:1], 96
  v_lshrrev_b32 v246, 6, v0
  v_and_b32 v1, 63, v0
  v_readfirstlane_b32 s3, v246
  v_lshrrev_b32 v2, 4, v1
  v_and_b32 v3, 15, v1
  v_lshlrev_b32 v247, 4, v3
  s_and_b32 s43, s2, 0xfc
  s_bfe_u32 s10, s2, 0x10001
  s_or_b32 s43, s43, s10
  s_and_b32 s10, s2, 1
  s_lshl_b32 s10, s10, 1
  s_or_b32 s43, s43, s10
  s_xor_b32 s43, s43, 6
  s_lshl_b32 s11, s3, 6
  s_and_b32 s10, s43, 1
  s_lshl_b32 s10, s10, 9
  s_add_u32 s10, s10, s11
  s_lshl_b32 s11, s3, 5
  s_lshl_b32 s12, s10, 13
  s_bfe_u32 s13, s43, 0x60001
  s_lshl_b32 s13, s13, 7
  s_add_u32 s12, s12, s13
  v_lshrrev_b32 v246, 3, v3
  v_lshlrev_b32 v246, 17, v246
  v_lshl_add_u32 v246, v2, 15, v246
  v_and_b32 v248, 7, v3
  v_lshl_add_u32 v246, v248, 4, v246
  v_add_u32 v8, s12, v246
  v_bfe_u32 v248, v1, 1, 2
  v_bfe_u32 v249, v1, 3, 1
  v_lshlrev_b32 v246, 11, v248
  v_lshl_add_u32 v246, v249, 5, v246
  v_lshl_add_u32 v246, v2, 3, v246
  s_lshl_b32 s10, s10, 1
  v_add_u32 v10, s10, v246
  s_mov_b32 s80, 0
  s_mov_b32 s81, 8192
  s_mov_b32 s82, 16384
  s_mov_b32 s83, 24576
  s_mov_b32 s84, 262144
  s_mov_b32 s85, 270336
  s_mov_b32 s86, 278528
  s_mov_b32 s87, 286720
  s_mov_b32 s62, 8388608
  s_mov_b32 s63, 0x00020000
  s_mov_b32 s70, 8192
  s_mov_b32 s71, 0x00020000
  s_and_b32 s4, s2, 7
  s_lshl_b32 s4, s4, 1
  s_bfe_u32 s5, s2, 0x10003
  s_add_u32 s4, s4, s5
  s_lshr_b32 s5, s2, 4
  s_lshr_b32 s14, s4, 3
  s_lshl_b32 s14, s14, 4
  s_add_u32 s14, s14, s5
  s_and_b32 s15, s4, 7
  s_cmp_ge_u32 s43, 128
  s_waitcnt lgkmcnt(0)
  s_cselect_b32 s60, s32, s22
  s_cselect_b32 s61, s33, s23
  s_cselect_b32 s68, s26, s16
  s_cselect_b32 s69, s27, s17
  buffer_load_dwordx2 v[232:233], v10, s[68:71], 0 offen
  buffer_load_dwordx2 v[234:235], v10, s[68:71], 0 offen offset:64
  buffer_load_dwordx4 v[176:179], v8, s[60:63], s80 offen nt
  buffer_load_dwordx4 v[180:183], v8, s[60:63], s81 offen nt
  buffer_load_dwordx4 v[184:187], v8, s[60:63], s82 offen nt
  buffer_load_dwordx4 v[188:191], v8, s[60:63], s83 offen nt
  buffer_load_dwordx4 v[192:195], v8, s[60:63], s84 offen nt
  buffer_load_dwordx4 v[196:199], v8, s[60:63], s85 offen nt
  buffer_load_dwordx4 v[200:203], v8, s[60:63], s86 offen nt
  buffer_load_dwordx4 v[204:207], v8, s[60:63], s87 offen nt
  s_load_dword s42, s[40:41], 0
  s_lshr_b32 s13, s2, 3
  s_add_u32 s13, s13, s3
  s_and_b32 s13, s13, 7
  s_lshl_b32 s6, s4, 21
  s_lshl_b32 s7, s5, 17
  s_add_u32 s7, s7, s6
  s_lshl_b32 s8, s13, 14
  s_add_u32 s7, s7, s8
  s_lshl_b32 s9, s5, 15
  s_add_u32 s9, s9, s6
  s_lshl_b32 s8, s13, 12
  s_add_u32 s9, s9, s8
  s_add_u32 s9, s9, 1572864
  v_lshlrev_b32 v246, 4, v1
  v_add_u32 v4, s7, v246
  v_add_u32 v5, s9, v246
  v_lshl_add_u32 v246, v2, 10, v247
  v_add_u32 v6, s7, v246
  v_add_u32 v7, s9, v246
  s_mov_b32 s52, s28
  s_mov_b32 s53, s29
  s_mov_b32 s54, 33554432
  s_mov_b32 s55, 0x00020000
  s_mov_b32 s44, s18
  s_mov_b32 s45, s19
  s_mov_b32 s46, 33554432
  s_mov_b32 s47, 0x00020000
  s_mov_b32 s48, s20
  s_mov_b32 s49, s21
  s_mov_b32 s50, 33554432
  s_mov_b32 s51, 0x00020000
  s_mov_b32 s56, s30
  s_mov_b32 s57, s31
  s_mov_b32 s58, 33554432
  s_mov_b32 s59, 0x00020000
  s_mov_b32 s96, 4096
  s_mov_b32 s97, 8192
  s_mov_b32 s98, 12288
  s_lshr_b32 s13, s2, 4
  s_add_u32 s13, s13, s2
  s_add_u32 s13, s13, s3
  s_add_u32 s28, s13, 0
  s_and_b32 s28, s28, 3
  s_lshl_b32 s28, s28, 12
  s_add_u32 s29, s13, 1
  s_and_b32 s29, s29, 3
  s_lshl_b32 s29, s29, 12
  s_add_u32 s30, s13, 2
  s_and_b32 s30, s30, 3
  s_lshl_b32 s30, s30, 12
  s_add_u32 s31, s13, 3
  s_and_b32 s31, s31, 3
  s_lshl_b32 s31, s31, 12
  s_barrier
  buffer_load_dwordx4 v[16:19], v5, s[52:55], 0 offen offset:0 nt
  buffer_load_dwordx4 v[20:23], v5, s[52:55], 0 offen offset:1024 nt
  buffer_load_dwordx4 v[24:27], v5, s[52:55], 0 offen offset:2048 nt
  s_cmp_ge_u32 s14, 16
  s_cselect_b32 s64, s34, s24
  s_cselect_b32 s65, s35, s25
  s_mov_b32 s66, 8388608
  s_mov_b32 s67, 0x00020000
  s_mov_b32 s33, s3
  s_lshl_b32 s11, s33, 5
  s_and_b32 s6, s14, 15
  s_lshl_b32 s6, s6, 8
  s_add_u32 s6, s6, s11
  s_lshl_b32 s6, s6, 11
  s_lshl_b32 s7, s15, 8
  s_add_u32 s6, s6, s7
  v_lshl_add_u32 v246, v2, 13, v247
  v_add_u32 v9, s6, v246
  s_mov_b32 s88, 0
  s_mov_b32 s89, 2048
  s_mov_b32 s90, 4096
  s_mov_b32 s91, 6144
  s_mov_b32 s92, 32768
  s_mov_b32 s93, 34816
  s_mov_b32 s94, 36864
  s_mov_b32 s95, 38912
  s_mov_b32 s72, s40
  s_mov_b32 s73, s41
  s_mov_b32 s74, 268435456
  s_mov_b32 s75, 0x00020000
  s_mov_b32 s76, s36
  s_mov_b32 s77, s37
  s_mov_b32 s78, 16384
  s_mov_b32 s79, 0x00020000
  s_mov_b32 s16, s4
  s_mov_b32 s17, s5
  s_mov_b32 s18, s14
  s_mov_b32 s19, s15
  v_and_b32 v246, 1, v1
  v_cmp_eq_u32 vcc, 0, v246
  v_mov_b32 v246, 0x01000c0c
  v_mov_b32 v247, 0x0c0c0100
  v_cndmask_b32 v11, v246, v247, vcc
  v_mov_b32 v246, 0x03020c0c
  v_mov_b32 v247, 0x0c0c0302
  v_cndmask_b32 v12, v246, v247, vcc
  v_cmp_eq_u32 vcc, 0, v249
  v_mov_b32 v246, 0x0c0c0c0c
  s_nop 0
  v_cndmask_b32 v13, v246, v11, vcc
  v_cndmask_b32 v14, v246, v12, vcc
  v_cndmask_b32 v15, v11, v246, vcc
  v_cndmask_b32 v244, v12, v246, vcc
  s_mov_b32 s8, 0x7060500
  s_mov_b32 s9, 0x7060501
  s_mov_b32 s10, 0x7060502
  s_mov_b32 s11, 0x7060503
  s_mov_b32 s12, 0x0c0c0400
  s_mov_b32 s13, 0x0c040100
  s_mov_b32 s14, 0x04020100
  s_mov_b32 s101, 0x3e0293ee
  v_lshrrev_b32 v246, 1, v2
  v_lshl_add_u32 v246, s3, 1, v246
  v_mul_u32_u24 v246, 2048, v246
  v_and_b32 v247, 1, v2
  v_lshl_add_u32 v246, v247, 10, v246
  v_lshl_add_u32 v250, v3, 5, v246
  v_bfe_u32 v247, v3, 2, 1
  v_lshl_add_u32 v250, v247, 4, v250
  v_lshrrev_b32 v247, 3, v3
  v_xor_b32 v247, v247, v3
  v_mul_u32_u24 v246, 8192, v2
  v_lshl_add_u32 v247, s3, 4, v247
  v_lshl_add_u32 v251, v247, 4, v246
  s_lshr_b32 s4, s43, 2
  s_and_b32 s4, s4, 31
  s_lshl_b32 s4, s4, 2
  s_lshr_b32 s5, s3, 1
  s_add_u32 s4, s4, s5
  s_mul_i32 s4, s4, 20480
  s_lshr_b32 s5, s43, 7
  s_lshl_b32 s5, s5, 10
  s_add_u32 s4, s4, s5
  s_and_b32 s5, s43, 1
  s_lshl_b32 s5, s5, 9
  s_add_u32 s4, s4, s5
  s_and_b32 s5, s43, 2
  s_lshl_b32 s5, s5, 7
  s_add_u32 s4, s4, s5
  s_and_b32 s5, s3, 1
  s_lshl_b32 s6, s5, 7
  s_add_u32 s4, s4, s6
  s_add_u32 s4, s4, 4194304
  v_and_b32 v247, 7, v1
  v_lshlrev_b32 v246, 4, v247
  v_add_u32 v252, s4, v246
  v_lshrrev_b32 v246, 1, v2
  v_lshl_add_u32 v246, s3, 1, v246
  v_mul_u32_u24 v246, 1088, v246
  v_and_b32 v240, 1, v2
  v_lshl_add_u32 v246, v240, 9, v246
  v_lshl_add_u32 v246, v247, 5, v246
  v_lshrrev_b32 v240, 2, v247
  v_lshl_add_u32 v240, v240, 4, v246
  v_lshrrev_b32 v246, 3, v1
  v_mul_u32_u24 v246, 2176, v246
  v_xor_b32 v241, s5, v247
  v_lshl_add_u32 v241, s3, 3, v241
  v_lshl_add_u32 v241, v241, 4, v246
  s_and_b32 s5, s16, 3
  s_lshl_b32 s5, s5, 3
  s_add_u32 s5, s5, s3
  s_lshl_b32 s5, s5, 2
  s_lshr_b32 s4, s16, 2
  s_add_u32 s5, s5, s4
  s_mul_i32 s5, s5, 20480
  s_add_u32 s5, s5, 4194304
  v_lshlrev_b32 v246, 4, v1
  v_add_u32 v253, s5, v246
  s_waitcnt lgkmcnt(0)
  s_add_u32 s100, s42, 1
  s_mul_i32 s99, s100, 0x9e3779b1
  s_lshr_b32 s4, s99, 15
  s_xor_b32 s99, s99, s4
  s_mul_i32 s99, s99, 0x85ebca6b
  s_lshr_b32 s4, s99, 13
  s_xor_b32 s99, s99, s4
  v_mov_b32 v245, s99
  s_getreg_b32 s25, hwreg(HW_REG_XCC_ID)
  s_mul_i32 s26, s16, 8448
  s_add_u32 s26, s26, 4096
  s_cmp_lg_u32 s3, 0
  s_cbranch_scc1 L_noxt
  s_lshl_b32 s4, s17, 3
  s_add_u32 s4, s4, s26
  v_mov_b32 v246, s4
  v_mov_b32 v208, s25
  v_mov_b32 v209, s99
  s_mov_b64 exec, 1
  buffer_store_dwordx2 v[208:209], v246, s[72:75], 0 offen sc1
  s_mov_b64 exec, -1
L_noxt:
  s_waitcnt vmcnt(11)
  v_perm_b32 v224, v232, v232, v11
  v_perm_b32 v225, v232, v232, v12
  v_perm_b32 v226, v233, v233, v11
  v_perm_b32 v227, v233, v233, v12
  v_perm_b32 v228, v234, v234, v11
  v_perm_b32 v229, v234, v234, v12
  v_perm_b32 v230, v235, v235, v11
  v_perm_b32 v231, v235, v235, v12
  s_waitcnt vmcnt(7)
  v_swap_b32 v177, v180
  v_swap_b32 v178, v184
  v_swap_b32 v179, v188
  v_swap_b32 v182, v185
  v_swap_b32 v183, v189
  v_swap_b32 v187, v190
  v_mfma_f32_16x16x32_bf16 v[208:211], v[224:227], v[176:179], 0
  v_mfma_f32_16x16x32_bf16 v[212:215], v[224:227], v[180:183], 0
  v_mfma_f32_16x16x32_bf16 v[216:219], v[224:227], v[184:187], 0
  v_mfma_f32_16x16x32_bf16 v[220:223], v[224:227], v[188:191], 0
  s_waitcnt vmcnt(3)
  v_swap_b32 v193, v196
  v_swap_b32 v194, v200
  v_swap_b32 v195, v204
  v_swap_b32 v198, v201
  v_swap_b32 v199, v205
  v_swap_b32 v203, v206
  v_mfma_f32_16x16x32_bf16 v[208:211], v[228:231], v[192:195], v[208:211]
  v_mfma_f32_16x16x32_bf16 v[212:215], v[228:231], v[196:199], v[212:215]
  v_mfma_f32_16x16x32_bf16 v[216:219], v[228:231], v[200:203], v[216:219]
  v_mfma_f32_16x16x32_bf16 v[220:223], v[228:231], v[204:207], v[220:223]
  v_xor_b32 v243, 16, v240
  s_mov_b32 exec_lo, 0x00ff00ff
  s_mov_b32 exec_hi, 0xff00ff00
  s_nop 2
  ds_write2_b64 v240, v[208:209], v[212:213] offset0:0 offset1:1
  ds_write2_b64 v240, v[210:211], v[214:215] offset0:32 offset1:33
  ds_write2_b64 v243, v[216:217], v[220:221] offset0:0 offset1:1
  ds_write2_b64 v243, v[218:219], v[222:223] offset0:32 offset1:33
  s_mov_b64 exec, -1
  buffer_load_dwordx4 v[28:31], v5, s[52:55], 0 offen offset:3072 nt
  buffer_load_dwordx4 v[32:35], v4, s[44:47], s28 offen offset:0 nt
  buffer_load_dwordx4 v[36:39], v4, s[44:47], s28 offen offset:1024 nt
  s_waitcnt lgkmcnt(0)
  s_barrier
  ds_read_b128 v[208:211], v241
  ds_read_b128 v[212:215], v241 offset:1088
  s_waitcnt lgkmcnt(0)
  v_pk_add_f32 v[208:209], v[208:209], v[212:213]
  v_pk_add_f32 v[210:211], v[210:211], v[214:215]
  s_nop 0
  v_add_f32_dpp v208, v208, v208 row_ror:8 row_mask:0xf bank_mask:0xf
  v_add_f32_dpp v209, v209, v209 row_ror:8 row_mask:0xf bank_mask:0xf
  v_add_f32_dpp v210, v210, v210 row_ror:8 row_mask:0xf bank_mask:0xf
  v_add_f32_dpp v211, v211, v211 row_ror:8 row_mask:0xf bank_mask:0xf
  s_nop 0
  v_permlane32_swap_b32 v208, v210
  v_permlane32_swap_b32 v209, v211
  v_add_f32 v208, v208, v210
  v_add_f32 v209, v209, v211
  s_nop 1
  v_permlane16_swap_b32 v208, v209
  v_add_f32 v208, v208, v209
  v_mov_b32 v209, v208
  s_nop 1
  v_permlane16_swap_b32 v208, v209
  v_mov_b32 v210, v208
  v_mov_b32 v211, v209
  s_nop 0
  v_permlane32_swap_b32 v208, v210
  v_permlane32_swap_b32 v209, v211
  v_perm_b32 v208, v208, v245, s8
  v_perm_b32 v209, v209, v245, s9
  v_perm_b32 v210, v210, v245, s10
  v_perm_b32 v211, v211, v245, s11
  s_mov_b64 exec, 0xff
  buffer_store_dwordx4 v[208:211], v252, s[72:75], 0 offen sc1
  s_mov_b64 exec, -1
  s_barrier
  buffer_load_dwordx4 v[40:43], v4, s[44:47], s28 offen offset:2048 nt
  buffer_load_dwordx4 v[44:47], v4, s[44:47], s28 offen offset:3072 nt
  buffer_load_dwordx4 v[48:51], v4, s[44:47], s29 offen offset:0 nt
  buffer_load_dwordx4 v[52:55], v4, s[44:47], s29 offen offset:1024 nt
  buffer_load_dwordx4 v[56:59], v4, s[44:47], s29 offen offset:2048 nt
  buffer_load_dwordx4 v[60:63], v4, s[44:47], s29 offen offset:3072 nt
  buffer_load_dwordx4 v[64:67], v4, s[44:47], s30 offen offset:0 nt
  buffer_load_dwordx4 v[68:71], v4, s[44:47], s30 offen offset:1024 nt
  buffer_load_dwordx4 v[72:75], v4, s[44:47], s30 offen offset:2048 nt
  buffer_load_dwordx4 v[76:79], v4, s[44:47], s30 offen offset:3072 nt
  buffer_load_dwordx4 v[80:83], v4, s[44:47], s31 offen offset:0 nt
  buffer_load_dwordx4 v[84:87], v4, s[44:47], s31 offen offset:1024 nt
  buffer_load_dwordx4 v[88:91], v4, s[44:47], s31 offen offset:2048 nt
  buffer_load_dwordx4 v[92:95], v4, s[44:47], s31 offen offset:3072 nt
  v_lshlrev_b32 v242, 3, v3
  v_add_u32 v242, s26, v242
  buffer_load_dwordx2 v[208:209], v242, s[72:75], 0 offen sc1
  buffer_load_dwordx4 v[228:231], v253, s[72:75], 0 offen offset:0 sc1
  buffer_load_dwordx4 v[236:239], v253, s[72:75], 0 offen offset:1024 sc1
  s_lshl_b32 s4, s3, 13
  s_add_u32 s4, s4, 39424
  v_add_u32 v246, 0, v2
  v_xor_b32 v247, v246, v3
  v_lshlrev_b32 v247, 4, v247
  v_lshl_add_u32 v212, v246, 8, v247
  v_lshl_add_u32 v216, v3, 8, v247
  v_add_u32 v212, s4, v212
  v_add_u32 v216, s4, v216
  v_add_u32 v246, 4, v2
  v_xor_b32 v247, v246, v3
  v_lshlrev_b32 v247, 4, v247
  v_lshl_add_u32 v213, v246, 8, v247
  v_lshl_add_u32 v217, v3, 8, v247
  v_add_u32 v213, s4, v213
  v_add_u32 v217, s4, v217
  v_add_u32 v246, 8, v2
  v_xor_b32 v247, v246, v3
  v_lshlrev_b32 v247, 4, v247
  v_lshl_add_u32 v214, v246, 8, v247
  v_lshl_add_u32 v218, v3, 8, v247
  v_add_u32 v214, s4, v214
  v_add_u32 v218, s4, v218
  v_add_u32 v246, 12, v2
  v_xor_b32 v247, v246, v3
  v_lshlrev_b32 v247, 4, v247
  v_lshl_add_u32 v215, v246, 8, v247
  v_lshl_add_u32 v219, v3, 8, v247
  v_add_u32 v215, s4, v215
  v_add_u32 v219, s4, v219
  s_cmp_ge_u32 s3, 4
  s_cbranch_scc1 L_tskip
  s_waitcnt vmcnt(20)
  ds_write_b128 v212, v[16:19] offset:0
  ds_write_b128 v213, v[20:23] offset:0
  ds_write_b128 v214, v[24:27] offset:0
  ds_write_b128 v215, v[28:31] offset:0
  ds_read_b128 v[16:19], v216 offset:0
  ds_read_b128 v[20:23], v217 offset:0
  ds_read_b128 v[24:27], v218 offset:0
  ds_read_b128 v[28:31], v219 offset:0
  s_waitcnt vmcnt(15)
  ds_write_b128 v212, v[32:35] offset:4096
  ds_write_b128 v213, v[36:39] offset:4096
  ds_write_b128 v214, v[40:43] offset:4096
  ds_write_b128 v215, v[44:47] offset:4096
  ds_read_b128 v[32:35], v216 offset:4096
  ds_read_b128 v[36:39], v217 offset:4096
  ds_read_b128 v[40:43], v218 offset:4096
  ds_read_b128 v[44:47], v219 offset:4096
  s_waitcnt vmcnt(11)
  ds_write_b128 v212, v[48:51] offset:0
  ds_write_b128 v213, v[52:55] offset:0
  ds_write_b128 v214, v[56:59] offset:0
  ds_write_b128 v215, v[60:63] offset:0
  ds_read_b128 v[48:51], v216 offset:0
  ds_read_b128 v[52:55], v217 offset:0
  ds_read_b128 v[56:59], v218 offset:0
  ds_read_b128 v[60:63], v219 offset:0
  s_waitcnt vmcnt(7)
  ds_write_b128 v212, v[64:67] offset:4096
  ds_write_b128 v213, v[68:71] offset:4096
  ds_write_b128 v214, v[72:75] offset:4096
  ds_write_b128 v215, v[76:79] offset:4096
  ds_read_b128 v[64:67], v216 offset:4096
  ds_read_b128 v[68:71], v217 offset:4096
  ds_read_b128 v[72:75], v218 offset:4096
  ds_read_b128 v[76:79], v219 offset:4096
  s_waitcnt vmcnt(3)
  ds_write_b128 v212, v[80:83] offset:0
  ds_write_b128 v213, v[84:87] offset:0
  ds_write_b128 v214, v[88:91] offset:0
  ds_write_b128 v215, v[92:95] offset:0
  ds_read_b128 v[80:83], v216 offset:0
  ds_read_b128 v[84:87], v217 offset:0
  ds_read_b128 v[88:91], v218 offset:0
  ds_read_b128 v[92:95], v219 offset:0
L_tskip:
  s_barrier
  buffer_load_dwordx4 v[96:99], v7, s[56:59], 0 offen offset:0 nt
  buffer_load_dwordx4 v[100:103], v7, s[56:59], 0 offen offset:256 nt
  buffer_load_dwordx4 v[104:107], v7, s[56:59], 0 offen offset:512 nt
  buffer_load_dwordx4 v[108:111], v7, s[56:59], 0 offen offset:768 nt
  v_lshrrev_b32 v246, 5, v1
  v_mul_u32_u24 v246, 2176, v246
  v_and_b32 v247, 31, v1
  v_lshl_add_u32 v246, v247, 3, v246
  s_mul_i32 s4, s3, 272
  v_add_u32 v252, s4, v246
  v_lshrrev_b32 v247, 1, v3
  v_mul_u32_u24 v247, 272, v247
  v_lshl_add_u32 v254, v2, 4, v247
  s_cmp_lt_u32 s3, 4
  s_cbranch_scc1 L_tdone
  s_waitcnt vmcnt(24)
  ds_write_b128 v212, v[16:19] offset:0
  ds_write_b128 v213, v[20:23] offset:0
  ds_write_b128 v214, v[24:27] offset:0
  ds_write_b128 v215, v[28:31] offset:0
  ds_read_b128 v[16:19], v216 offset:0
  ds_read_b128 v[20:23], v217 offset:0
  ds_read_b128 v[24:27], v218 offset:0
  ds_read_b128 v[28:31], v219 offset:0
  s_waitcnt vmcnt(19)
  ds_write_b128 v212, v[32:35] offset:4096
  ds_write_b128 v213, v[36:39] offset:4096
  ds_write_b128 v214, v[40:43] offset:4096
  ds_write_b128 v215, v[44:47] offset:4096
  ds_read_b128 v[32:35], v216 offset:4096
  ds_read_b128 v[36:39], v217 offset:4096
  ds_read_b128 v[40:43], v218 offset:4096
  ds_read_b128 v[44:47], v219 offset:4096
  s_waitcnt vmcnt(15)
  ds_write_b128 v212, v[48:51] offset:0
  ds_write_b128 v213, v[52:55] offset:0
  ds_write_b128 v214, v[56:59] offset:0
  ds_write_b128 v215, v[60:63] offset:0
  ds_read_b128 v[48:51], v216 offset:0
  ds_read_b128 v[52:55], v217 offset:0
  ds_read_b128 v[56:59], v218 offset:0
  ds_read_b128 v[60:63], v219 offset:0
  s_waitcnt vmcnt(11)
  ds_write_b128 v212, v[64:67] offset:4096
  ds_write_b128 v213, v[68:71] offset:4096
  ds_write_b128 v214, v[72:75] offset:4096
  ds_write_b128 v215, v[76:79] offset:4096
  ds_read_b128 v[64:67], v216 offset:4096
  ds_read_b128 v[68:71], v217 offset:4096
  ds_read_b128 v[72:75], v218 offset:4096
  ds_read_b128 v[76:79], v219 offset:4096
  s_waitcnt vmcnt(7)
  ds_write_b128 v212, v[80:83] offset:0
  ds_write_b128 v213, v[84:87] offset:0
  ds_write_b128 v214, v[88:91] offset:0
  ds_write_b128 v215, v[92:95] offset:0
  ds_read_b128 v[80:83], v216 offset:0
  ds_read_b128 v[84:87], v217 offset:0
  ds_read_b128 v[88:91], v218 offset:0
  ds_read_b128 v[92:95], v219 offset:0
L_tdone:
  s_mov_b32 s15, 0
  s_waitcnt vmcnt(4)
  v_cmp_ne_u32 s[6:7], s25, v208
  v_cmp_ne_u32 vcc, v245, v209
  s_or_b64 s[6:7], s[6:7], vcc
  s_cmp_eq_u64 s[6:7], 0
  s_cselect_b32 s22, 1, 0
  s_nop 1
L_qchk:
  v_perm_b32 v246, v229, v228, s12
  v_perm_b32 v246, v230, v246, s13
  v_perm_b32 v246, v231, v246, s14
  v_cmp_ne_u32 s[6:7], v246, v245
  v_perm_b32 v246, v237, v236, s12
  v_perm_b32 v246, v238, v246, s13
  v_perm_b32 v246, v239, v246, s14
  v_cmp_ne_u32 vcc, v246, v245
  s_or_b64 s[6:7], s[6:7], vcc
  s_cmp_eq_u64 s[6:7], 0
  s_nop 1
  s_cbranch_scc1 L_qok
  s_add_u32 s15, s15, 1
  s_cmp_gt_u32 s15, 1000000
  s_cbranch_scc1 L_qok
  buffer_load_dwordx4 v[228:231], v253, s[72:75], 0 offen offset:0 sc1
  buffer_load_dwordx4 v[236:239], v253, s[72:75], 0 offen offset:1024 sc1
  s_waitcnt vmcnt(0)
  s_branch L_qchk
L_qok:
  v_and_b32 v228, 0xffffff00, v228
  v_and_b32 v229, 0xffffff00, v229
  v_and_b32 v230, 0xffffff00, v230
  v_and_b32 v231, 0xffffff00, v231
  v_and_b32 v236, 0xffffff00, v236
  v_and_b32 v237, 0xffffff00, v237
  v_and_b32 v238, 0xffffff00, v238
  v_and_b32 v239, 0xffffff00, v239
  v_permlane32_swap_b32 v228, v236
  v_permlane32_swap_b32 v229, v237
  v_permlane32_swap_b32 v230, v238
  v_permlane32_swap_b32 v231, v239
  v_pk_add_f32 v[228:229], v[228:229], v[236:237]
  v_pk_add_f32 v[230:231], v[230:231], v[238:239]
  v_cvt_pk_bf16_f32 v228, v228, v229
  v_cvt_pk_bf16_f32 v229, v230, v231
  ds_write_b64 v252, v[228:229] offset:33024
  s_waitcnt lgkmcnt(0)
  s_barrier
  ds_read_b128 v[192:195], v254 offset:35200
  ds_read_b128 v[196:199], v254 offset:35264
  ds_read_b128 v[200:203], v254 offset:35328
  ds_read_b128 v[204:207], v254 offset:35392
  ds_read_b128 v[176:179], v254 offset:33024
  ds_read_b128 v[180:183], v254 offset:33088
  ds_read_b128 v[184:187], v254 offset:33152
  ds_read_b128 v[188:191], v254 offset:33216
  v_lshrrev_b32 v246, 5, v1
  v_lshl_add_u32 v246, v246, 4, v3
  v_lshlrev_b32 v246, 5, v246
  v_lshl_add_u32 v253, s3, 2, v246
  v_lshlrev_b32 v252, 5, v3
  s_waitcnt lgkmcnt(0)
  v_mfma_f32_16x16x32_bf16 v[208:211], v[16:19], v[192:195], 0
  v_mfma_f32_16x16x32_bf16 v[212:215], v[32:35], v[176:179], 0
  v_mfma_f32_16x16x32_bf16 v[216:219], v[48:51], v[176:179], 0
  v_mfma_f32_16x16x32_bf16 v[220:223], v[64:67], v[176:179], 0
  v_mfma_f32_16x16x32_bf16 v[224:227], v[80:83], v[176:179], 0
  v_mfma_f32_16x16x32_bf16 v[208:211], v[20:23], v[196:199], v[208:211]
  v_mfma_f32_16x16x32_bf16 v[212:215], v[36:39], v[180:183], v[212:215]
  v_mfma_f32_16x16x32_bf16 v[216:219], v[52:55], v[180:183], v[216:219]
  v_mfma_f32_16x16x32_bf16 v[220:223], v[68:71], v[180:183], v[220:223]
  v_mfma_f32_16x16x32_bf16 v[224:227], v[84:87], v[180:183], v[224:227]
  v_mfma_f32_16x16x32_bf16 v[208:211], v[24:27], v[200:203], v[208:211]
  v_mfma_f32_16x16x32_bf16 v[212:215], v[40:43], v[184:187], v[212:215]
  v_mfma_f32_16x16x32_bf16 v[216:219], v[56:59], v[184:187], v[216:219]
  v_mfma_f32_16x16x32_bf16 v[220:223], v[72:75], v[184:187], v[220:223]
  v_mfma_f32_16x16x32_bf16 v[224:227], v[88:91], v[184:187], v[224:227]
  v_mfma_f32_16x16x32_bf16 v[208:211], v[28:31], v[204:207], v[208:211]
  v_mfma_f32_16x16x32_bf16 v[212:215], v[44:47], v[188:191], v[212:215]
  v_mfma_f32_16x16x32_bf16 v[216:219], v[60:63], v[188:191], v[216:219]
  v_mfma_f32_16x16x32_bf16 v[220:223], v[76:79], v[188:191], v[220:223]
  v_mfma_f32_16x16x32_bf16 v[224:227], v[92:95], v[188:191], v[224:227]
  buffer_load_dwordx4 v[112:115], v6, s[48:51], s28 offen offset:0 nt
  buffer_load_dwordx4 v[116:119], v6, s[48:51], s28 offen offset:256 nt
  buffer_load_dwordx4 v[120:123], v6, s[48:51], s28 offen offset:512 nt
  buffer_load_dwordx4 v[124:127], v6, s[48:51], s28 offen offset:768 nt
  v_max3_f32 v81, v208, v209, v210
  v_max_f32 v81, v81, v211
  v_max3_f32 v80, v212, v213, v214
  v_max3_f32 v80, v80, v215, v216
  v_max3_f32 v80, v80, v217, v218
  v_max3_f32 v80, v80, v219, v220
  v_max3_f32 v80, v80, v221, v222
  v_max3_f32 v80, v80, v223, v224
  v_max3_f32 v80, v80, v225, v226
  v_max_f32 v80, v80, v227
  s_nop 1
  v_permlane32_swap_b32 v80, v81
  v_max_f32 v80, v80, v81
  v_mov_b32 v82, v80
  s_nop 1
  v_permlane16_swap_b32 v80, v82
  v_max_f32 v80, v80, v82
  ds_write_b32 v253, v80 offset:37376
  s_waitcnt lgkmcnt(0)
  s_barrier
  ds_read_b128 v[176:179], v252 offset:37376
  ds_read_b128 v[180:183], v252 offset:37392
  ds_read_b128 v[184:187], v252 offset:37888
  ds_read_b128 v[188:191], v252 offset:37904
  s_waitcnt lgkmcnt(0)
  v_max3_f32 v80, v176, v177, v178
  v_max3_f32 v80, v80, v179, v180
  v_max3_f32 v80, v80, v181, v182
  v_max_f32 v80, v80, v183
  v_max3_f32 v81, v184, v185, v186
  v_max3_f32 v81, v81, v187, v188
  v_max3_f32 v81, v81, v189, v190
  v_max_f32 v81, v81, v191
  v_mul_f32 v80, s101, v80
  v_mul_f32 v81, s101, v81
  v_fma_f32 v208, v208, s101, -v81
  v_fma_f32 v209, v209, s101, -v81
  v_fma_f32 v210, v210, s101, -v81
  v_fma_f32 v211, v211, s101, -v81
  v_fma_f32 v212, v212, s101, -v80
  v_fma_f32 v213, v213, s101, -v80
  v_fma_f32 v214, v214, s101, -v80
  v_fma_f32 v215, v215, s101, -v80
  v_fma_f32 v216, v216, s101, -v80
  v_fma_f32 v217, v217, s101, -v80
  v_fma_f32 v218, v218, s101, -v80
  v_fma_f32 v219, v219, s101, -v80
  v_fma_f32 v220, v220, s101, -v80
  v_fma_f32 v221, v221, s101, -v80
  v_fma_f32 v222, v222, s101, -v80
  v_fma_f32 v223, v223, s101, -v80
  v_fma_f32 v224, v224, s101, -v80
  v_fma_f32 v225, v225, s101, -v80
  v_fma_f32 v226, v226, s101, -v80
  v_fma_f32 v227, v227, s101, -v80
  v_exp_f32 v208, v208
  v_exp_f32 v209, v209
  v_exp_f32 v210, v210
  v_exp_f32 v211, v211
  v_exp_f32 v212, v212
  v_exp_f32 v213, v213
  v_exp_f32 v214, v214
  v_exp_f32 v215, v215
  v_exp_f32 v216, v216
  v_exp_f32 v217, v217
  v_exp_f32 v218, v218
  v_exp_f32 v219, v219
  v_exp_f32 v220, v220
  v_exp_f32 v221, v221
  v_exp_f32 v222, v222
  v_exp_f32 v223, v223
  v_exp_f32 v224, v224
  v_exp_f32 v225, v225
  v_exp_f32 v226, v226
  v_exp_f32 v227, v227
  v_add_f32 v85, v208, v209
  v_add_f32 v85, v85, v210
  v_add_f32 v85, v85, v211
  v_add_f32 v84, v212, v213
  v_add_f32 v84, v84, v214
  v_add_f32 v84, v84, v215
  v_add_f32 v84, v84, v216
  v_add_f32 v84, v84, v217
  v_add_f32 v84, v84, v218
  v_add_f32 v84, v84, v219
  v_add_f32 v84, v84, v220
  v_add_f32 v84, v84, v221
  v_add_f32 v84, v84, v222
  v_add_f32 v84, v84, v223
  v_add_f32 v84, v84, v224
  v_add_f32 v84, v84, v225
  v_add_f32 v84, v84, v226
  v_add_f32 v84, v84, v227
  s_nop 1
  v_permlane32_swap_b32 v84, v85
  v_add_f32 v84, v84, v85
  v_mov_b32 v82, v84
  s_nop 1
  v_permlane16_swap_b32 v84, v82
  v_add_f32 v84, v84, v82
  ds_write_b32 v253, v84 offset:38400
  s_lshl_b32 s4, s3, 1
  v_readlane_b32 s42, v80, s4
  v_readlane_b32 s43, v81, s4
  v_cvt_pk_bf16_f32 v86, v208, v209
  v_cvt_pk_bf16_f32 v87, v210, v211
  v_perm_b32 v208, v86, v86, v11
  v_perm_b32 v209, v86, v86, v12
  v_perm_b32 v210, v87, v87, v11
  v_perm_b32 v211, v87, v87, v12
  v_cvt_pk_bf16_f32 v86, v212, v213
  v_cvt_pk_bf16_f32 v87, v214, v215
  v_perm_b32 v212, v86, v86, v11
  v_perm_b32 v213, v86, v86, v12
  v_perm_b32 v214, v87, v87, v11
  v_perm_b32 v215, v87, v87, v12
  v_cvt_pk_bf16_f32 v86, v216, v217
  v_cvt_pk_bf16_f32 v87, v218, v219
  v_perm_b32 v216, v86, v86, v11
  v_perm_b32 v217, v86, v86, v12
  v_perm_b32 v218, v87, v87, v11
  v_perm_b32 v219, v87, v87, v12
  v_cvt_pk_bf16_f32 v86, v220, v221
  v_cvt_pk_bf16_f32 v87, v222, v223
  v_perm_b32 v220, v86, v86, v11
  v_perm_b32 v221, v86, v86, v12
  v_perm_b32 v222, v87, v87, v11
  v_perm_b32 v223, v87, v87, v12
  v_cvt_pk_bf16_f32 v86, v224, v225
  v_cvt_pk_bf16_f32 v87, v226, v227
  v_perm_b32 v224, v86, v86, v11
  v_perm_b32 v225, v86, v86, v12
  v_perm_b32 v226, v87, v87, v11
  v_perm_b32 v227, v87, v87, v12
  buffer_load_dwordx4 v[128:131], v6, s[48:51], s29 offen offset:0 nt
  buffer_load_dwordx4 v[132:135], v6, s[48:51], s29 offen offset:256 nt
  buffer_load_dwordx4 v[136:139], v6, s[48:51], s29 offen offset:512 nt
  buffer_load_dwordx4 v[140:143], v6, s[48:51], s29 offen offset:768 nt
  buffer_load_dwordx4 v[144:147], v6, s[48:51], s30 offen offset:0 nt
  buffer_load_dwordx4 v[148:151], v6, s[48:51], s30 offen offset:256 nt
  buffer_load_dwordx4 v[152:155], v6, s[48:51], s30 offen offset:512 nt
  buffer_load_dwordx4 v[156:159], v6, s[48:51], s30 offen offset:768 nt
  s_mul_i32 s4, s3, 4128
  v_lshlrev_b32 v246, 10, v2
  v_lshl_add_u32 v246, v3, 5, v246
  v_bfe_u32 v247, v3, 2, 1
  v_lshl_add_u32 v246, v247, 4, v246
  v_add_u32 v88, s4, v246
  v_lshrrev_b32 v246, 3, v3
  v_and_b32 v247, 31, v1
  v_xor_b32 v247, v247, v246
  v_lshrrev_b32 v246, 5, v1
  v_mul_u32_u24 v246, 16512, v246
  v_lshl_add_u32 v247, s3, 5, v247
  v_lshl_add_u32 v89, v247, 4, v246
  s_lshl_b32 s5, s16, 17
  s_lshl_b32 s6, s3, 13
  s_add_u32 s5, s5, s6
  s_lshl_b32 s7, s17, 8
  s_add_u32 s5, s5, s7
  s_add_u32 s5, s5, 2097152
  v_and_b32 v246, 1, v2
  v_lshlrev_b32 v246, 12, v246
  v_lshl_add_u32 v246, v3, 4, v246
  v_add_u32 v90, s5, v246
  s_lshl_b32 s5, s16, 4
  s_add_u32 s5, s5, s3
  s_mul_i32 s5, s5, 8448
  s_lshl_b32 s7, s17, 3
  s_add_u32 s5, s5, s7
  s_add_u32 s5, s5, 7340032
  v_mov_b32 v91, s5
  s_lshl_b32 s4, s3, 6
  v_mov_b32 v92, s4
  s_mov_b32 s20, 65536
  s_mov_b32 s21, 67584
  s_waitcnt vmcnt(12)
  v_swap_b32 v97, v100
  v_swap_b32 v98, v104
  v_swap_b32 v99, v108
  v_swap_b32 v102, v105
  v_swap_b32 v103, v109
  v_swap_b32 v107, v110
  v_mfma_f32_16x16x32_bf16 v[32:35], v[208:211], v[96:99], 0
  v_mfma_f32_16x16x32_bf16 v[36:39], v[208:211], v[100:103], 0
  v_mfma_f32_16x16x32_bf16 v[40:43], v[208:211], v[104:107], 0
  v_mfma_f32_16x16x32_bf16 v[44:47], v[208:211], v[108:111], 0
  v_add_u32 v246, 39424, v88
  v_xor_b32 v243, 16, v246
  s_nop 3
  ds_write2_b64 v246, v[32:33], v[36:37] offset0:0 offset1:1
  ds_write2_b64 v246, v[34:35], v[38:39] offset0:64 offset1:65
  ds_write2_b64 v243, v[40:41], v[44:45] offset0:0 offset1:1
  ds_write2_b64 v243, v[42:43], v[46:47] offset0:64 offset1:65
  v_add_u32 v247, 39424, v89
  s_waitcnt lgkmcnt(0)
  s_barrier
  ds_read_b128 v[176:179], v247 offset:0
  ds_read_b128 v[180:183], v247 offset:4128
  ds_read_b128 v[184:187], v247 offset:8256
  ds_read_b128 v[188:191], v247 offset:12384
  ds_read_b128 v[192:195], v92 offset:38912
  ds_read_b128 v[196:199], v92 offset:38928
  ds_read_b128 v[200:203], v92 offset:38400
  ds_read_b128 v[204:207], v92 offset:38416
  s_waitcnt lgkmcnt(0)
  v_pk_add_f32 v[192:193], v[192:193], v[194:195]
  v_pk_add_f32 v[196:197], v[196:197], v[198:199]
  v_pk_add_f32 v[192:193], v[192:193], v[196:197]
  v_add_f32 v192, v192, v193
  v_rcp_f32 v194, v192
  v_log_f32 v196, v192
  v_mov_b32 v197, v245
  v_add_f32 v196, s43, v196
  v_pk_add_f32 v[200:201], v[200:201], v[202:203]
  v_pk_add_f32 v[204:205], v[204:205], v[206:207]
  v_pk_add_f32 v[200:201], v[200:201], v[204:205]
  v_add_f32 v200, v200, v201
  v_rcp_f32 v93, v200
  v_log_f32 v204, v200
  v_mov_b32 v205, v245
  v_add_f32 v204, s42, v204
  v_pk_add_f32 v[176:177], v[176:177], v[180:181]
  v_pk_add_f32 v[178:179], v[178:179], v[182:183]
  v_pk_add_f32 v[184:185], v[184:185], v[188:189]
  v_pk_add_f32 v[186:187], v[186:187], v[190:191]
  v_pk_add_f32 v[176:177], v[176:177], v[184:185]
  v_pk_add_f32 v[178:179], v[178:179], v[186:187]
  s_nop 0
  v_permlane32_swap_b32 v176, v177
  v_permlane32_swap_b32 v178, v179
  v_add_f32 v176, v176, v177
  v_add_f32 v178, v178, v179
  v_mul_f32 v176, v176, v194
  v_mul_f32 v178, v178, v194
  v_mov_b32 v177, v176
  v_mov_b32 v179, v178
  s_nop 0
  v_permlane32_swap_b32 v176, v177
  v_permlane32_swap_b32 v178, v179
  v_perm_b32 v176, v176, v245, s8
  v_perm_b32 v177, v177, v245, s9
  v_perm_b32 v178, v178, v245, s10
  v_perm_b32 v179, v179, v245, s11
  s_cmp_lg_u32 s22, 0
  s_cbranch_scc1 L_sl0
  s_mov_b32 exec_lo, -1
  s_mov_b32 exec_hi, 0
  buffer_store_dwordx4 v[176:179], v90, s[72:75], s20 offen sc1
  s_mov_b64 exec, 1
  buffer_store_dwordx2 v[196:197], v91, s[72:75], s21 offen sc1
  buffer_store_dwordx2 v[204:205], v91, s[72:75], 0 offen sc1
  s_branch L_sd0
L_sl0:
  s_mov_b32 exec_lo, -1
  s_mov_b32 exec_hi, 0
  buffer_store_dwordx4 v[176:179], v90, s[72:75], s20 offen
  s_mov_b64 exec, 1
  buffer_store_dwordx2 v[196:197], v91, s[72:75], s21 offen
  buffer_store_dwordx2 v[204:205], v91, s[72:75], 0 offen
L_sd0:
  s_mov_b64 exec, -1
  s_barrier
  buffer_load_dwordx4 v[160:163], v6, s[48:51], s31 offen offset:0 nt
  buffer_load_dwordx4 v[164:167], v6, s[48:51], s31 offen offset:256 nt
  buffer_load_dwordx4 v[168:171], v6, s[48:51], s31 offen offset:512 nt
  buffer_load_dwordx4 v[172:175], v6, s[48:51], s31 offen offset:768 nt
  s_lshl_b32 s4, s16, 1
  s_and_b32 s5, s3, 1
  s_add_u32 s4, s4, s5
  s_lshl_b32 s6, s4, 4
  s_add_u32 s6, s6, s17
  s_lshl_b32 s6, s6, 12
  s_add_u32 s6, s6, 2097152
  v_lshlrev_b32 v246, 4, v1
  v_add_u32 v252, s6, v246
  s_lshl_b32 s6, s4, 3
  s_lshr_b32 s7, s17, 1
  s_add_u32 s6, s6, s7
  s_mul_i32 s6, s6, 8448
  s_add_u32 s6, s6, 7340032
  v_lshlrev_b32 v246, 3, v3
  v_add_u32 v253, s6, v246
  s_lshl_b32 s6, s5, 7
  s_and_b32 s7, s16, 3
  s_lshl_b32 s7, s7, 5
  s_add_u32 s6, s6, s7
  s_lshl_b32 s7, s17, 1
  s_add_u32 s6, s6, s7
  s_mul_i32 s6, s6, 8704
  s_lshr_b32 s7, s16, 2
  s_lshl_b32 s7, s7, 7
  s_add_u32 s6, s6, s7
  s_add_u32 s6, s6, 13631488
  v_lshrrev_b32 v246, 3, v3
  v_mul_u32_u24 v246, 8704, v246
  v_and_b32 v247, 7, v3
  v_lshl_add_u32 v246, v247, 4, v246
  v_add_u32 v7, s6, v246
  v_lshlrev_b32 v254, 2, v2
  s_cmp_eq_u32 s3, 0
  s_cselect_b32 s4, s17, 255
  v_mov_b32 v247, 0x7ffffff0
  v_lshlrev_b32 v232, 4, v3
  v_add_u32 v246, 0, v2
  v_cmp_eq_u32 s[28:29], s4, v246
  s_nop 1
  v_cndmask_b32 v228, v252, v247, s[28:29]
  v_add_u32 v246, 4, v2
  v_cmp_eq_u32 s[30:31], s4, v246
  s_nop 1
  v_cndmask_b32 v229, v252, v247, s[30:31]
  v_add_u32 v246, 8, v2
  v_cmp_eq_u32 s[34:35], s4, v246
  s_nop 1
  v_cndmask_b32 v230, v252, v247, s[34:35]
  v_add_u32 v246, 12, v2
  v_cmp_eq_u32 s[36:37], s4, v246
  s_nop 1
  v_cndmask_b32 v231, v252, v247, s[36:37]
  s_lshl_b32 s6, s18, 3
  s_add_u32 s6, s6, s33
  s_mul_i32 s6, s6, 8704
  s_add_u32 s6, s6, 13631488
  v_and_b32 v246, 31, v1
  v_lshlrev_b32 v246, 4, v246
  v_add_u32 v8, s6, v246
  v_lshlrev_b32 v246, 5, v248
  v_lshl_add_u32 v246, v249, 4, v246
  v_lshl_add_u32 v10, v2, 2, v246
  s_lshr_b32 s4, s18, 4
  s_lshl_b32 s4, s4, 3
  s_add_u32 s4, s4, s19
  s_lshl_b32 s4, s4, 4
  s_and_b32 s5, s18, 15
  s_lshl_b32 s6, s3, 1
  s_add_u32 s6, s6, s4
  s_mul_i32 s6, s6, 10240
  s_lshl_b32 s7, s5, 7
  s_add_u32 s6, s6, s7
  s_add_u32 s6, s6, 10485760
  v_lshrrev_b32 v246, 3, v3
  v_mul_u32_u24 v246, 10240, v246
  v_and_b32 v247, 7, v3
  v_lshl_add_u32 v246, v247, 4, v246
  v_add_u32 v4, s6, v246
  s_add_u32 s6, s4, s5
  s_mul_i32 s6, s6, 10240
  s_add_u32 s6, s6, 10485760
  v_lshlrev_b32 v246, 4, v1
  v_add_u32 v5, s6, v246
  s_waitcnt vmcnt(15)
  v_swap_b32 v113, v116
  v_swap_b32 v114, v120
  v_swap_b32 v115, v124
  v_swap_b32 v118, v121
  v_swap_b32 v119, v125
  v_swap_b32 v123, v126
  v_mfma_f32_16x16x32_bf16 v[16:19], v[212:215], v[112:115], 0
  v_mfma_f32_16x16x32_bf16 v[20:23], v[212:215], v[116:119], 0
  v_mfma_f32_16x16x32_bf16 v[24:27], v[212:215], v[120:123], 0
  v_mfma_f32_16x16x32_bf16 v[28:31], v[212:215], v[124:127], 0
  s_waitcnt vmcnt(11)
  v_swap_b32 v129, v132
  v_swap_b32 v130, v136
  v_swap_b32 v131, v140
  v_swap_b32 v134, v137
  v_swap_b32 v135, v141
  v_swap_b32 v139, v142
  v_mfma_f32_16x16x32_bf16 v[16:19], v[216:219], v[128:131], v[16:19]
  v_mfma_f32_16x16x32_bf16 v[20:23], v[216:219], v[132:135], v[20:23]
  v_mfma_f32_16x16x32_bf16 v[24:27], v[216:219], v[136:139], v[24:27]
  v_mfma_f32_16x16x32_bf16 v[28:31], v[216:219], v[140:143], v[28:31]
  s_waitcnt vmcnt(7)
  v_swap_b32 v145, v148
  v_swap_b32 v146, v152
  v_swap_b32 v147, v156
  v_swap_b32 v150, v153
  v_swap_b32 v151, v157
  v_swap_b32 v155, v158
  v_mfma_f32_16x16x32_bf16 v[16:19], v[220:223], v[144:147], v[16:19]
  v_mfma_f32_16x16x32_bf16 v[20:23], v[220:223], v[148:151], v[20:23]
  v_mfma_f32_16x16x32_bf16 v[24:27], v[220:223], v[152:155], v[24:27]
  v_mfma_f32_16x16x32_bf16 v[28:31], v[220:223], v[156:159], v[28:31]
  s_waitcnt vmcnt(0)
  v_swap_b32 v161, v164
  v_swap_b32 v162, v168
  v_swap_b32 v163, v172
  v_swap_b32 v166, v169
  v_swap_b32 v167, v173
  v_swap_b32 v171, v174
  v_mfma_f32_16x16x32_bf16 v[16:19], v[224:227], v[160:163], v[16:19]
  v_mfma_f32_16x16x32_bf16 v[20:23], v[224:227], v[164:167], v[20:23]
  v_mfma_f32_16x16x32_bf16 v[24:27], v[224:227], v[168:171], v[24:27]
  v_mfma_f32_16x16x32_bf16 v[28:31], v[224:227], v[172:175], v[28:31]
  v_add_u32 v246, 72448, v88
  v_xor_b32 v243, 16, v246
  s_nop 3
  ds_write2_b64 v246, v[16:17], v[20:21] offset0:0 offset1:1
  ds_write2_b64 v246, v[18:19], v[22:23] offset0:64 offset1:65
  ds_write2_b64 v243, v[24:25], v[28:29] offset0:0 offset1:1
  ds_write2_b64 v243, v[26:27], v[30:31] offset0:64 offset1:65
  v_add_u32 v247, 72448, v89
  s_waitcnt lgkmcnt(0)
  s_barrier
  ds_read_b128 v[176:179], v247 offset:0
  ds_read_b128 v[180:183], v247 offset:4128
  ds_read_b128 v[184:187], v247 offset:8256
  ds_read_b128 v[188:191], v247 offset:12384
  s_waitcnt lgkmcnt(0)
  v_pk_add_f32 v[176:177], v[176:177], v[180:181]
  v_pk_add_f32 v[178:179], v[178:179], v[182:183]
  v_pk_add_f32 v[184:185], v[184:185], v[188:189]
  v_pk_add_f32 v[186:187], v[186:187], v[190:191]
  v_pk_add_f32 v[176:177], v[176:177], v[184:185]
  v_pk_add_f32 v[178:179], v[178:179], v[186:187]
  s_nop 0
  v_permlane32_swap_b32 v176, v177
  v_permlane32_swap_b32 v178, v179
  v_add_f32 v176, v176, v177
  v_add_f32 v178, v178, v179
  v_mul_f32 v176, v176, v93
  v_mul_f32 v178, v178, v93
  v_mov_b32 v177, v176
  v_mov_b32 v179, v178
  s_nop 0
  v_permlane32_swap_b32 v176, v177
  v_permlane32_swap_b32 v178, v179
  v_perm_b32 v176, v176, v245, s8
  v_perm_b32 v177, v177, v245, s9
  v_perm_b32 v178, v178, v245, s10
  v_perm_b32 v179, v179, v245, s11
  s_cmp_lg_u32 s22, 0
  s_cbranch_scc1 L_sl1
  s_mov_b32 exec_lo, -1
  s_mov_b32 exec_hi, 0
  buffer_store_dwordx4 v[176:179], v90, s[72:75], 0 offen sc1
  s_nop 0
  s_branch L_sd1
L_sl1:
  s_mov_b32 exec_lo, -1
  s_mov_b32 exec_hi, 0
  buffer_store_dwordx4 v[176:179], v90, s[72:75], 0 offen
  s_nop 1
L_sd1:
  s_mov_b64 exec, -1
  s_lshr_b32 s4, s17, 1
  s_cmp_lg_u32 s4, s3
  s_cbranch_scc1 L_nown
  s_and_b32 s4, s17, 1
  s_lshl_b32 s4, s4, 4
  s_lshl_b32 exec_lo, 0xffff, s4
  s_mov_b32 exec_hi, 0
  ds_write_b128 v232, v[176:179] offset:37376
  s_mov_b64 exec, -1
  s_waitcnt lgkmcnt(0)
L_nown:
  s_barrier
  s_mov_b32 s23, 0
  s_mov_b32 s24, 0
  s_mov_b32 s15, 0
  s_cmp_gt_u32 s3, 1
  s_cbranch_scc1 L_cng
  buffer_load_dwordx2 v[112:113], v253, s[72:75], 0 offen sc1 nt
  buffer_load_dwordx4 v[96:99], v228, s[72:75], 0 offen offset:0 sc1 nt
  buffer_load_dwordx4 v[100:103], v229, s[72:75], 0 offen offset:1024 sc1 nt
  buffer_load_dwordx4 v[104:107], v230, s[72:75], 0 offen offset:2048 sc1 nt
  buffer_load_dwordx4 v[108:111], v231, s[72:75], 0 offen offset:3072 sc1 nt
  ds_read_b128 v[124:127], v232 offset:37376
L_cng:
  s_cmp_lt_u32 s3, 1
  s_cbranch_scc1 L_w0s
  buffer_load_dwordx4 v[48:51], v9, s[64:67], s88 offen nt
  buffer_load_dwordx4 v[52:55], v9, s[64:67], s89 offen nt
  buffer_load_dwordx4 v[56:59], v9, s[64:67], s90 offen nt
  buffer_load_dwordx4 v[60:63], v9, s[64:67], s91 offen nt
  buffer_load_dwordx4 v[64:67], v9, s[64:67], s92 offen nt
  s_cmp_gt_u32 s3, 1
  s_cbranch_scc1 L_cskip
  s_waitcnt vmcnt(5)
  s_branch L_cchk
L_w0s:
  s_waitcnt vmcnt(0)
  s_branch L_cchk
L_c:
  s_add_u32 s15, s15, 1
  s_cmp_gt_u32 s15, 1000000
  s_cbranch_scc1 L_cdo
  buffer_load_dwordx2 v[112:113], v253, s[72:75], 0 offen sc1 nt
  buffer_load_dwordx4 v[96:99], v228, s[72:75], 0 offen offset:0 sc1 nt
  buffer_load_dwordx4 v[100:103], v229, s[72:75], 0 offen offset:1024 sc1 nt
  buffer_load_dwordx4 v[104:107], v230, s[72:75], 0 offen offset:2048 sc1 nt
  buffer_load_dwordx4 v[108:111], v231, s[72:75], 0 offen offset:3072 sc1 nt
  s_waitcnt vmcnt(0)
L_cchk:
  s_waitcnt lgkmcnt(0)
  v_cndmask_b32 v96, v96, v124, s[28:29]
  v_cndmask_b32 v97, v97, v125, s[28:29]
  v_cndmask_b32 v98, v98, v126, s[28:29]
  v_cndmask_b32 v99, v99, v127, s[28:29]
  v_cndmask_b32 v100, v100, v124, s[30:31]
  v_cndmask_b32 v101, v101, v125, s[30:31]
  v_cndmask_b32 v102, v102, v126, s[30:31]
  v_cndmask_b32 v103, v103, v127, s[30:31]
  v_cndmask_b32 v104, v104, v124, s[34:35]
  v_cndmask_b32 v105, v105, v125, s[34:35]
  v_cndmask_b32 v106, v106, v126, s[34:35]
  v_cndmask_b32 v107, v107, v127, s[34:35]
  v_cndmask_b32 v108, v108, v124, s[36:37]
  v_cndmask_b32 v109, v109, v125, s[36:37]
  v_cndmask_b32 v110, v110, v126, s[36:37]
  v_cndmask_b32 v111, v111, v127, s[36:37]
  v_perm_b32 v246, v97, v96, s12
  v_perm_b32 v246, v98, v246, s13
  v_perm_b32 v246, v99, v246, s14
  v_cmp_ne_u32 s[6:7], v246, v245
  v_perm_b32 v246, v101, v100, s12
  v_perm_b32 v246, v102, v246, s13
  v_perm_b32 v246, v103, v246, s14
  v_cmp_ne_u32 vcc, v246, v245
  s_or_b64 s[6:7], s[6:7], vcc
  v_perm_b32 v246, v105, v104, s12
  v_perm_b32 v246, v106, v246, s13
  v_perm_b32 v246, v107, v246, s14
  v_cmp_ne_u32 vcc, v246, v245
  s_or_b64 s[6:7], s[6:7], vcc
  v_perm_b32 v246, v109, v108, s12
  v_perm_b32 v246, v110, v246, s13
  v_perm_b32 v246, v111, v246, s14
  v_cmp_ne_u32 vcc, v246, v245
  s_or_b64 s[6:7], s[6:7], vcc
  v_cmp_ne_u32 vcc, v113, v245
  s_or_b64 s[6:7], s[6:7], vcc
  s_cmp_eq_u64 s[6:7], 0
  s_nop 1
  s_cbranch_scc1 L_cdo
  s_branch L_c
L_cdo:
  v_mov_b32 v144, v112
  s_nop 1
  v_max_f32_dpp v144, v144, v144 row_ror:8 row_mask:0xf bank_mask:0xf
  s_nop 1
  v_max_f32_dpp v144, v144, v144 row_ror:4 row_mask:0xf bank_mask:0xf
  s_nop 1
  v_max_f32_dpp v144, v144, v144 row_ror:2 row_mask:0xf bank_mask:0xf
  s_nop 1
  v_max_f32_dpp v144, v144, v144 row_ror:1 row_mask:0xf bank_mask:0xf
  v_sub_f32 v112, v112, v144
  v_exp_f32 v112, v112
  s_nop 0
  v_mov_b32 v145, v112
  s_nop 1
  v_add_f32_dpp v145, v145, v145 row_ror:8 row_mask:0xf bank_mask:0xf
  s_nop 1
  v_add_f32_dpp v145, v145, v145 row_ror:4 row_mask:0xf bank_mask:0xf
  s_nop 1
  v_add_f32_dpp v145, v145, v145 row_ror:2 row_mask:0xf bank_mask:0xf
  s_nop 1
  v_add_f32_dpp v145, v145, v145 row_ror:1 row_mask:0xf bank_mask:0xf
  v_rcp_f32 v145, v145
  s_nop 0
  v_mul_f32 v112, v112, v145
  ds_bpermute_b32 v114, v254, v112 offset:0
  ds_bpermute_b32 v115, v254, v112 offset:16
  ds_bpermute_b32 v116, v254, v112 offset:32
  ds_bpermute_b32 v117, v254, v112 offset:48
  v_and_b32 v96, 0xffffff00, v96
  v_and_b32 v97, 0xffffff00, v97
  v_and_b32 v98, 0xffffff00, v98
  v_and_b32 v99, 0xffffff00, v99
  v_and_b32 v100, 0xffffff00, v100
  v_and_b32 v101, 0xffffff00, v101
  v_and_b32 v102, 0xffffff00, v102
  v_and_b32 v103, 0xffffff00, v103
  v_and_b32 v104, 0xffffff00, v104
  v_and_b32 v105, 0xffffff00, v105
  v_and_b32 v106, 0xffffff00, v106
  v_and_b32 v107, 0xffffff00, v107
  v_and_b32 v108, 0xffffff00, v108
  v_and_b32 v109, 0xffffff00, v109
  v_and_b32 v110, 0xffffff00, v110
  v_and_b32 v111, 0xffffff00, v111
  s_waitcnt lgkmcnt(0)
  v_mul_f32 v148, v114, v96
  v_mul_f32 v149, v114, v97
  v_mul_f32 v150, v114, v98
  v_mul_f32 v151, v114, v99
  v_fmac_f32 v148, v115, v100
  v_fmac_f32 v149, v115, v101
  v_fmac_f32 v150, v115, v102
  v_fmac_f32 v151, v115, v103
  v_fmac_f32 v148, v116, v104
  v_fmac_f32 v149, v116, v105
  v_fmac_f32 v150, v116, v106
  v_fmac_f32 v151, v116, v107
  v_fmac_f32 v148, v117, v108
  v_fmac_f32 v149, v117, v109
  v_fmac_f32 v150, v117, v110
  v_fmac_f32 v151, v117, v111
  s_nop 0
  v_permlane32_swap_b32 v148, v150
  v_permlane32_swap_b32 v149, v151
  v_add_f32 v148, v148, v150
  v_add_f32 v149, v149, v151
  s_nop 1
  v_permlane16_swap_b32 v148, v149
  v_add_f32 v148, v148, v149
  v_mov_b32 v149, v148
  s_nop 1
  v_permlane16_swap_b32 v148, v149
  v_mov_b32 v150, v148
  v_mov_b32 v151, v149
  s_nop 0
  v_permlane32_swap_b32 v148, v150
  v_permlane32_swap_b32 v149, v151
  v_perm_b32 v148, v148, v245, s8
  v_perm_b32 v149, v149, v245, s9
  v_perm_b32 v150, v150, v245, s10
  v_perm_b32 v151, v151, v245, s11
  s_mov_b64 exec, 0xffff
  buffer_store_dwordx4 v[148:151], v7, s[72:75], 0 offen sc1
  s_mov_b64 exec, -1
  s_mov_b32 s24, 0
  s_cmp_lg_u32 s23, 0
  s_cbranch_scc1 L_cend
L_cskip:
  s_barrier
  s_cmp_ge_u32 s3, 1
  s_cbranch_scc1 L_w0d
  buffer_load_dwordx4 v[48:51], v9, s[64:67], s88 offen nt
  buffer_load_dwordx4 v[52:55], v9, s[64:67], s89 offen nt
  buffer_load_dwordx4 v[56:59], v9, s[64:67], s90 offen nt
  buffer_load_dwordx4 v[60:63], v9, s[64:67], s91 offen nt
  buffer_load_dwordx4 v[64:67], v9, s[64:67], s92 offen nt
L_w0d:
  buffer_load_dwordx4 v[68:71], v9, s[64:67], s93 offen nt
  buffer_load_dwordx4 v[72:75], v9, s[64:67], s94 offen nt
  buffer_load_dwordx4 v[76:79], v9, s[64:67], s95 offen nt
  s_mov_b32 s23, 1
  s_cmp_lg_u32 s24, 0
  s_cbranch_scc1 L_c
L_cend:
  s_cmp_lg_u32 s3, 0
  s_cbranch_scc1 L_nfpt
  buffer_load_dwordx4 v[128:131], v5, s[72:75], 0 offen sc1
  buffer_load_dwordx4 v[128:131], v5, s[72:75], 0 offen offset:1024 sc1
L_nfpt:
  buffer_load_dwordx4 v[120:123], v8, s[72:75], 0 offen sc1
  s_waitcnt vmcnt(5)
  v_swap_b32 v49, v52
  v_swap_b32 v50, v56
  v_swap_b32 v51, v60
  v_swap_b32 v54, v57
  v_swap_b32 v55, v61
  v_swap_b32 v59, v62
  s_waitcnt vmcnt(1)
  v_swap_b32 v65, v68
  v_swap_b32 v66, v72
  v_swap_b32 v67, v76
  v_swap_b32 v70, v73
  v_swap_b32 v71, v77
  v_swap_b32 v75, v78
  s_mov_b32 s15, 0
  s_waitcnt vmcnt(0)
L_ochk:
  v_perm_b32 v246, v121, v120, s12
  v_perm_b32 v246, v122, v246, s13
  v_perm_b32 v246, v123, v246, s14
  v_cmp_ne_u32 s[6:7], v246, v245
  s_cmp_eq_u64 s[6:7], 0
  s_nop 2
  s_cbranch_scc1 L_ook
  s_add_u32 s15, s15, 1
  s_cmp_gt_u32 s15, 1000000
  s_cbranch_scc1 L_ook
  buffer_load_dwordx4 v[120:123], v8, s[72:75], 0 offen sc1
  s_waitcnt vmcnt(0)
  s_branch L_ochk
L_ook:
  v_and_b32 v120, 0xffffff00, v120
  v_and_b32 v121, 0xffffff00, v121
  v_and_b32 v122, 0xffffff00, v122
  v_and_b32 v123, 0xffffff00, v123
  v_cvt_pk_bf16_f32 v154, v120, v121
  v_cvt_pk_bf16_f32 v155, v122, v123
  ds_bpermute_b32 v152, v10, v154
  ds_bpermute_b32 v153, v10, v155
  s_waitcnt lgkmcnt(0)
  v_perm_b32 v224, v152, v152, v13
  v_perm_b32 v225, v152, v152, v14
  v_perm_b32 v226, v153, v153, v13
  v_perm_b32 v227, v153, v153, v14
  v_perm_b32 v228, v152, v152, v15
  v_perm_b32 v229, v152, v152, v244
  v_perm_b32 v230, v153, v153, v15
  v_perm_b32 v231, v153, v153, v244
  v_mfma_f32_16x16x32_bf16 v[208:211], v[224:227], v[48:51], 0
  v_mfma_f32_16x16x32_bf16 v[212:215], v[224:227], v[52:55], 0
  v_mfma_f32_16x16x32_bf16 v[216:219], v[224:227], v[56:59], 0
  v_mfma_f32_16x16x32_bf16 v[220:223], v[224:227], v[60:63], 0
  v_mfma_f32_16x16x32_bf16 v[208:211], v[228:231], v[64:67], v[208:211]
  v_mfma_f32_16x16x32_bf16 v[212:215], v[228:231], v[68:71], v[212:215]
  v_mfma_f32_16x16x32_bf16 v[216:219], v[228:231], v[72:75], v[216:219]
  v_mfma_f32_16x16x32_bf16 v[220:223], v[228:231], v[76:79], v[220:223]
  s_nop 7
L_pdone:
  v_xor_b32 v243, 16, v250
  ds_write2_b64 v250, v[208:209], v[212:213] offset0:0 offset1:1
  ds_write2_b64 v250, v[210:211], v[214:215] offset0:64 offset1:65
  ds_write2_b64 v243, v[216:217], v[220:221] offset0:0 offset1:1
  ds_write2_b64 v243, v[218:219], v[222:223] offset0:64 offset1:65
  s_waitcnt lgkmcnt(0)
  s_barrier
  ds_read_b128 v[208:211], v251 offset:0
  ds_read_b128 v[212:215], v251 offset:2048
  ds_read_b128 v[216:219], v251 offset:4096
  ds_read_b128 v[220:223], v251 offset:6144
  s_waitcnt lgkmcnt(0)
  v_pk_add_f32 v[208:209], v[208:209], v[212:213]
  v_pk_add_f32 v[210:211], v[210:211], v[214:215]
  v_pk_add_f32 v[216:217], v[216:217], v[220:221]
  v_pk_add_f32 v[218:219], v[218:219], v[222:223]
  v_pk_add_f32 v[208:209], v[208:209], v[216:217]
  v_pk_add_f32 v[210:211], v[210:211], v[218:219]
  s_nop 1
  v_permlane32_swap_b32 v208, v210
  v_permlane32_swap_b32 v209, v211
  v_add_f32 v208, v208, v210
  v_add_f32 v209, v209, v211
  s_nop 1
  v_permlane16_swap_b32 v208, v209
  v_add_f32 v208, v208, v209
  v_mov_b32 v209, v208
  s_nop 1
  v_permlane16_swap_b32 v208, v209
  v_mov_b32 v210, v208
  v_mov_b32 v211, v209
  s_nop 0
  v_permlane32_swap_b32 v208, v210
  v_permlane32_swap_b32 v209, v211
  v_perm_b32 v208, v208, v245, s8
  v_perm_b32 v209, v209, v245, s9
  v_perm_b32 v210, v210, v245, s10
  v_perm_b32 v211, v211, v245, s11
  s_cmp_lg_u32 s22, 0
  s_cbranch_scc1 L_sl2
  s_mov_b64 exec, 0xffff
  buffer_store_dwordx4 v[208:211], v4, s[72:75], 0 offen sc1
  s_nop 0
  s_branch L_sd2
L_sl2:
  s_mov_b64 exec, 0xffff
  buffer_store_dwordx4 v[208:211], v4, s[72:75], 0 offen
  s_nop 1
L_sd2:
  s_mov_b64 exec, -1
  s_cmp_lg_u32 s3, 0
  s_cbranch_scc1 L_fin
  s_and_b32 s4, s18, 15
  s_lshr_b32 s5, s4, 2
  s_lshl_b32 s5, s5, 12
  s_and_b32 s4, s4, 3
  s_lshl_b32 s4, s4, 6
  s_add_u32 s5, s5, s4
  s_lshr_b32 s4, s18, 4
  s_lshl_b32 s4, s4, 11
  s_add_u32 s5, s5, s4
  s_lshl_b32 s4, s19, 8
  s_add_u32 s5, s5, s4
  v_and_b32 v252, 7, v1
  v_lshlrev_b32 v252, 3, v252
  v_and_b32 v247, 1, v2
  v_lshl_add_u32 v252, v247, 2, v252
  v_lshrrev_b32 v247, 1, v2
  v_lshl_add_u32 v252, v247, 1, v252
  v_add_u32 v252, s5, v252
  s_mov_b32 s15, 0
  s_nop 0
L_fl:
  buffer_load_dwordx4 v[96:99], v5, s[72:75], 0 offen sc1 nt
  buffer_load_dwordx4 v[100:103], v5, s[72:75], 0 offen offset:1024 sc1 nt
  s_waitcnt vmcnt(0)
  v_perm_b32 v246, v97, v96, s12
  v_perm_b32 v246, v98, v246, s13
  v_perm_b32 v246, v99, v246, s14
  v_cmp_ne_u32 s[6:7], v246, v245
  v_perm_b32 v246, v101, v100, s12
  v_perm_b32 v246, v102, v246, s13
  v_perm_b32 v246, v103, v246, s14
  v_cmp_ne_u32 vcc, v246, v245
  s_or_b64 s[6:7], s[6:7], vcc
  s_cmp_eq_u64 s[6:7], 0
  s_nop 1
  s_cbranch_scc1 L_fok
  s_add_u32 s15, s15, 1
  s_cmp_gt_u32 s15, 1000000
  s_cbranch_scc0 L_fl
L_fok:
  v_and_b32 v96, 0xffffff00, v96
  v_and_b32 v97, 0xffffff00, v97
  v_and_b32 v98, 0xffffff00, v98
  v_and_b32 v99, 0xffffff00, v99
  v_and_b32 v100, 0xffffff00, v100
  v_and_b32 v101, 0xffffff00, v101
  v_and_b32 v102, 0xffffff00, v102
  v_and_b32 v103, 0xffffff00, v103
  v_pk_add_f32 v[96:97], v[96:97], v[100:101]
  v_pk_add_f32 v[98:99], v[98:99], v[102:103]
  s_nop 0
  v_permlane32_swap_b32 v96, v97
  v_permlane32_swap_b32 v98, v99
  v_add_f32 v96, v96, v97
  v_add_f32 v98, v98, v99
  s_nop 1
  v_permlane16_swap_b32 v96, v98
  v_add_f32 v96, v96, v98
  s_nop 1
  v_add_f32_dpp v96, v96, v96 row_ror:8 row_mask:0xf bank_mask:0xf
  v_cvt_pk_bf16_f32 v96, v96, v96
  s_mov_b32 exec_lo, 0x00ff00ff
  s_mov_b32 exec_hi, 0x00ff00ff
  buffer_store_short v96, v252, s[76:79], 0 offen
  s_mov_b64 exec, -1
  s_cmp_lg_u32 s2, 0
  s_cbranch_scc1 L_fin
  v_mov_b32 v246, 0
  v_mov_b32 v247, s100
  s_mov_b64 exec, 1
  buffer_store_dword v247, v246, s[72:75], 0 offen
  s_mov_b64 exec, -1
L_fin:
L_end:
  s_endpgm
.section .rodata,"a"
.p2align 6
.amdhsa_kernel concat_heads__gqa_block_cached__sliding_block_cached__decode_kernel
  .amdhsa_next_free_vgpr 256
  .amdhsa_next_free_sgpr 102
  .amdhsa_accum_offset 256
  .amdhsa_group_segment_fixed_size 0
  .amdhsa_kernarg_size 104
  .amdhsa_user_sgpr_count 2
  .amdhsa_user_sgpr_kernarg_segment_ptr 1
  .amdhsa_system_sgpr_workgroup_id_x 1
.end_amdhsa_kernel
```
